```python
import torch

def _softmax(x, axis=-1):
    return torch.softmax(x, dim=axis)
def _gelu(x):
    return torch.nn.functional.gelu(x, approximate="tanh")
def _silu(x):
    return torch.nn.functional.silu(x)
def _sigmoid(x):
    return torch.sigmoid(x)
def _layernorm(x, axis=-1, eps=1e-5):
    m = x.mean(dim=axis, keepdim=True)
    v = x.var(dim=axis, keepdim=True, unbiased=False)
    return (x - m) / torch.sqrt(v + eps)
def _scatter_add(tgt, idx, src, axis=0):
    return tgt.clone().index_add_(axis, idx, src)
def _segment_sum(src, seg, n):
    out = torch.zeros((n,) + src.shape[1:], dtype=src.dtype)
    return out.index_add_(0, seg, src)
def _pad(x, pw):
    flat = tuple(v for pair in reversed(pw) for v in pair)
    return torch.nn.functional.pad(x, flat)

kernel_name = 'standalone__depthwise_separable__vision'

def setup_inputs():

    _w = (lambda a: (lambda t: t.to(torch.bfloat16) if t.is_floating_point() else t)(torch.as_tensor(a)))
    H = W = 384
    C = 96
    k = 3
    return {
        "x": _w((lambda *s: torch.randn(*s, dtype=torch.bfloat16) * 0.05)(1, H, W, C)),
        "dw": _w((lambda *s: torch.randn(*s, dtype=torch.bfloat16) * 0.05)(k, k, C)),
        "pw": _w((lambda *s: torch.randn(*s, dtype=torch.bfloat16) * 0.05)(C, C)),
    }

def reference(x, dw, pw):
    B, H, W, C = x.shape
    k = dw.shape[0]
    pad = k // 2
    xp = _pad(x, ((0,0),(pad,pad),(pad,pad),(0,0)))
    out = torch.zeros_like(x)
    for i in range(k):
        for j in range(k):
            out = out + xp[:, i:i+H, j:j+W, :] * dw[i, j][None, None, None, :]
    return torch.einsum('bhwc,cd->bhwd', out, pw)
```

```asm
; @launch grid=(256,1,1) block=(256,1,1) lds=160384
.amdgcn_target "amdgcn-amd-amdhsa--gfx950"
.text
.globl standalone__depthwise_separable__vision_kernel
.p2align 8
.type standalone__depthwise_separable__vision_kernel,@function
standalone__depthwise_separable__vision_kernel:
    s_load_dwordx8 s[4:11], s[0:1], 0
    v_readfirstlane_b32 s28, v0
    s_cmp_ge_u32 s2, 256
    s_cbranch_scc1 L_end
    s_and_b32 s29, s2, 7
    s_lshr_b32 s3, s2, 7
    s_lshl1_add_u32 s29, s29, s3
    s_bfe_u32 s30, s2, 0x40003
    s_mul_i32 s31, s30, 4608
    s_mul_i32 s46, s29, 1769472
    v_and_b32 v0, 63, v0
    v_lshlrev_b32 v4, 4, v0
    s_lshr_b32 s28, s28, 6
    s_cbranch_scc0 L_mover
    s_getpc_b64 s[40:41]
L_pc:
    v_lshlrev_b32 v6, 7, v0
    v_min_u32 v6, L_end - L_pc, v6
    v_mov_b32 v7, s41
    v_add_co_u32 v6, vcc, s40, v6
    s_cmp_eq_u32 s28, 1
    s_cbranch_scc0 L_nopf
    v_addc_co_u32 v7, vcc, 0, v7, vcc
    global_load_dword v85, v[6:7], off
L_nopf:
    s_barrier
    s_branch L_compute
L_mover:
    v_and_b32 v94, 12, v0
    v_mov_b32 v97, 0
    v_add_u32 v94, 154080, v94
    ds_write_b32 v94, v97
    s_add_u32 s3, s31, 768
    v_add_u32 v2, s3, v4
    v_subrev_u32 v1, 1024, v2
    v_mov_b32 v5, 1073741824
    s_cmp_eq_u32 s30, 0
    s_cselect_b32 s32, 16, 0
    s_cmp_eq_u32 s30, 15
    s_cselect_b32 s33, 48, 64
    v_cmp_gt_u32 vcc, s32, v0
    s_sub_u32 s35, s46, 73728
    s_mov_b32 s36, 20544
    v_cndmask_b32 v1, v1, v5, vcc
    v_cmp_le_u32 vcc, s33, v0
    s_mov_b32 s15, 0x20000
    s_movk_i32 s18, 1728
    v_cndmask_b32 v3, v2, v5, vcc
    s_mov_b32 s19, 0x20000
    s_movk_i32 m0, 18432
    s_mov_b32 s39, 0
    s_waitcnt lgkmcnt(0)
    s_mov_b64 s[16:17], s[6:7]
    s_mov_b64 s[12:13], s[4:5]
    buffer_load_dwordx4 v4, s[16:19], 0 offen lds
    buffer_load_dwordx4 v4, s[16:19], 0 offen offset:1024 lds
    s_barrier
    s_mov_b64 s[16:17], s[8:9]
    s_movk_i32 s18, 18432
L_row0:
    s_mov_b32 m0, s39
    v_mov_b32 v97, 5136
    buffer_load_dwordx4 v4, s[16:19], s39 offen lds
    buffer_load_dwordx4 v4, s[16:19], s39 offen offset:1024 lds
    buffer_load_dwordx4 v4, s[16:19], s39 offen offset:2048 lds
    s_addk_i32 s39, 3072
    s_cmp_lt_u32 s35, 28311552
    s_cselect_b32 s14, 28311552, 0
    s_cselect_b32 s38, s35, 0
    s_mov_b32 m0, s36
    s_add_u32 s35, s35, 73728
    buffer_load_dwordx4 v1, s[12:15], s38 offen lds
    s_add_u32 m0, s36, 1024
    s_add_u32 s36, s36, 5136
    buffer_load_dwordx4 v2, s[12:15], s38 offen lds
    buffer_load_dwordx4 v2, s[12:15], s38 offen offset:1024 lds
    buffer_load_dwordx4 v2, s[12:15], s38 offen offset:2048 lds
    buffer_load_dwordx4 v3, s[12:15], s38 offen offset:3072 lds
    s_cmp_lt_u32 s36, 51360
    s_cbranch_scc1 L_row0
    v_mov_b32 v96, 154080
    s_waitcnt vmcnt(48)
    ds_write_b32 v96, v97
    v_mov_b32 v84, 27880
L_row:
    s_cmp_lt_u32 s35, 28311552
    s_cselect_b32 s14, 28311552, 0
    s_cselect_b32 s38, s35, 0
    s_mov_b32 m0, s36
    s_add_u32 s35, s35, 73728
    buffer_load_dwordx4 v1, s[12:15], s38 offen lds
    s_add_u32 m0, s36, 1024
    s_add_u32 s36, s36, 5136
    buffer_load_dwordx4 v2, s[12:15], s38 offen lds
    buffer_load_dwordx4 v2, s[12:15], s38 offen offset:1024 lds
    buffer_load_dwordx4 v2, s[12:15], s38 offen offset:2048 lds
    buffer_load_dwordx4 v3, s[12:15], s38 offen offset:3072 lds
    s_waitcnt vmcnt(39)
    s_cmp_lt_u32 s36, 82176
    s_cbranch_scc1 L_row
    v_add_u32 v84, 2936, v84
    v_min_u32 v97, 51360, v84
    s_waitcnt vmcnt(30)
    ds_write_b32 v96, v97
    s_cmp_lt_u32 s36, 154080
    s_cbranch_scc1 L_row
    v_and_b32 v5, 31, v0
    v_lshrrev_b32 v6, 5, v0
    v_lshlrev_b32 v7, 4, v5
    v_add_u32 v7, 4096, v7
    v_mov_b32 v85, v4
    v_mul_u32_u24 v86, 5136, v6
    v_add_u32 v86, v86, v7
    v_mul_u32_u24 v6, 73728, v6
    v_add3_u32 v83, v7, v6, s31
    v_add_u32 v80, s31, v4
    v_mov_b32 v81, v80
    v_mov_b32 v82, v80
    v_add_u32 v7, 0, v0
    v_mul_u32_u24 v7, 2731, v7
    v_bfe_u32 v7, v7, 16, 1
    v_lshlrev_b32 v7, 4, v7
    v_xor_b32 v80, v80, v7
    v_add_u32 v7, 16, v0
    v_mul_u32_u24 v7, 2731, v7
    v_bfe_u32 v7, v7, 16, 1
    v_lshlrev_b32 v7, 4, v7
    v_xor_b32 v81, v81, v7
    v_add_u32 v7, 32, v0
    v_mul_u32_u24 v7, 2731, v7
    v_bfe_u32 v7, v7, 16, 1
    v_lshlrev_b32 v7, 4, v7
    v_xor_b32 v82, v82, v7
    v_add_u32 v7, 16, v5
    v_mul_u32_u24 v7, 2731, v7
    v_bfe_u32 v7, v7, 16, 1
    v_lshlrev_b32 v7, 4, v7
    v_xor_b32 v83, v83, v7
    v_max_u32 v94, 154084, v94
    s_mov_b64 s[24:25], s[10:11]
    s_mov_b32 s26, 28311552
    s_mov_b32 s27, 0x20000
    s_add_u32 s47, s46, 73728
    s_add_u32 s48, s47, 73728
    s_add_u32 s49, s48, 73728
    s_mov_b32 s37, 92448
L_poll0:
    ds_read_b32 v95, v94
    s_waitcnt lgkmcnt(0)
    v_cmp_gt_u32 vcc, s37, v95
    s_cbranch_vccnz L_poll0
    ds_read_b128 v[8:11], v85 offset:0
    ds_read_b128 v[12:15], v85 offset:1024
    ds_read_b128 v[16:19], v85 offset:2048
    ds_read_b128 v[20:23], v85 offset:3072
    ds_read_b128 v[24:27], v86 offset:0
    ds_read_b128 v[28:31], v85 offset:5136
    ds_read_b128 v[32:35], v85 offset:6160
    ds_read_b128 v[36:39], v85 offset:7184
    ds_read_b128 v[40:43], v85 offset:8208
    v_mov_b32 v97, 92448
    s_waitcnt vmcnt(30)
    ds_write_b32 v96, v97
    v_mov_b32 v97, 112992
    s_waitcnt vmcnt(20)
    ds_write_b32 v96, v97
    s_waitcnt vmcnt(15)
    s_branch L_quad
L_poll:
    ds_read_b32 v95, v94
    s_waitcnt lgkmcnt(0)
    v_cmp_gt_u32 vcc, s37, v95
    s_cbranch_vccnz L_poll
    ds_read_b128 v[8:11], v85 offset:0
    ds_read_b128 v[12:15], v85 offset:1024
    ds_read_b128 v[16:19], v85 offset:2048
    ds_read_b128 v[20:23], v85 offset:3072
    ds_read_b128 v[24:27], v86 offset:0
    ds_read_b128 v[28:31], v85 offset:5136
    ds_read_b128 v[32:35], v85 offset:6160
    ds_read_b128 v[36:39], v85 offset:7184
    ds_read_b128 v[40:43], v85 offset:8208
L_quad:
    ds_read_b32 v95, v94
    s_waitcnt lgkmcnt(9)
    buffer_store_dwordx4 v[8:11], v80, s[24:27], s46 offen offset:0 sc1
    ds_read_b128 v[44:47], v85 offset:10272
    s_waitcnt lgkmcnt(9)
    buffer_store_dwordx4 v[12:15], v81, s[24:27], s46 offen offset:1024 sc1
    ds_read_b128 v[48:51], v85 offset:11296
    s_waitcnt lgkmcnt(9)
    buffer_store_dwordx4 v[16:19], v82, s[24:27], s46 offen offset:2048 sc1
    ds_read_b128 v[52:55], v85 offset:12320
    s_waitcnt lgkmcnt(9)
    buffer_store_dwordx4 v[20:23], v80, s[24:27], s46 offen offset:3072 sc1
    ds_read_b128 v[56:59], v85 offset:13344
    s_waitcnt lgkmcnt(9)
    buffer_store_dwordx4 v[24:27], v83, s[24:27], s46 offen sc1
    ds_read_b128 v[60:63], v86 offset:10272
    s_waitcnt lgkmcnt(9)
    buffer_store_dwordx4 v[28:31], v80, s[24:27], s47 offen offset:0 sc1
    ds_read_b128 v[64:67], v85 offset:15408
    s_waitcnt lgkmcnt(9)
    buffer_store_dwordx4 v[32:35], v81, s[24:27], s47 offen offset:1024 sc1
    ds_read_b128 v[68:71], v85 offset:16432
    s_waitcnt lgkmcnt(9)
    buffer_store_dwordx4 v[36:39], v82, s[24:27], s47 offen offset:2048 sc1
    ds_read_b128 v[72:75], v85 offset:17456
    s_waitcnt lgkmcnt(9)
    buffer_store_dwordx4 v[40:43], v80, s[24:27], s47 offen offset:3072 sc1
    ds_read_b128 v[76:79], v85 offset:18480
    v_add_u32 v85, 20544, v85
    v_add_u32 v86, 20544, v86
    s_add_u32 s37, s37, 20544
    s_add_u32 s46, s46, 294912
    s_add_u32 s47, s47, 294912
    s_waitcnt lgkmcnt(8)
    v_cmp_gt_u32 vcc, s37, v95
    s_cbranch_vccnz L_slow
    s_waitcnt lgkmcnt(8)
    buffer_store_dwordx4 v[44:47], v80, s[24:27], s48 offen offset:0 sc1
    ds_read_b128 v[8:11], v85 offset:0
    s_waitcnt lgkmcnt(8)
    buffer_store_dwordx4 v[48:51], v81, s[24:27], s48 offen offset:1024 sc1
    ds_read_b128 v[12:15], v85 offset:1024
    s_waitcnt lgkmcnt(8)
    buffer_store_dwordx4 v[52:55], v82, s[24:27], s48 offen offset:2048 sc1
    ds_read_b128 v[16:19], v85 offset:2048
    s_waitcnt lgkmcnt(8)
    buffer_store_dwordx4 v[56:59], v80, s[24:27], s48 offen offset:3072 sc1
    ds_read_b128 v[20:23], v85 offset:3072
    s_waitcnt lgkmcnt(8)
    buffer_store_dwordx4 v[60:63], v83, s[24:27], s48 offen sc1
    ds_read_b128 v[24:27], v86 offset:0
    s_waitcnt lgkmcnt(8)
    buffer_store_dwordx4 v[64:67], v80, s[24:27], s49 offen offset:0 sc1
    ds_read_b128 v[28:31], v85 offset:5136
    s_waitcnt lgkmcnt(8)
    buffer_store_dwordx4 v[68:71], v81, s[24:27], s49 offen offset:1024 sc1
    ds_read_b128 v[32:35], v85 offset:6160
    s_waitcnt lgkmcnt(8)
    buffer_store_dwordx4 v[72:75], v82, s[24:27], s49 offen offset:2048 sc1
    ds_read_b128 v[36:39], v85 offset:7184
    s_waitcnt lgkmcnt(8)
    buffer_store_dwordx4 v[76:79], v80, s[24:27], s49 offen offset:3072 sc1
    ds_read_b128 v[40:43], v85 offset:8208
    s_add_u32 s48, s48, 294912
    s_add_u32 s49, s49, 294912
    s_cmp_eq_u32 s37, 112992
    s_cbranch_scc0 L_npb2
    v_mov_b32 v97, 328704
    s_waitcnt vmcnt(18)
    ds_write_b32 v96, v97
L_npb2:
    s_branch L_quad
L_slow:
    s_waitcnt lgkmcnt(8)
    buffer_store_dwordx4 v[44:47], v80, s[24:27], s48 offen offset:0 sc1
    s_waitcnt lgkmcnt(7)
    buffer_store_dwordx4 v[48:51], v81, s[24:27], s48 offen offset:1024 sc1
    s_waitcnt lgkmcnt(6)
    buffer_store_dwordx4 v[52:55], v82, s[24:27], s48 offen offset:2048 sc1
    s_waitcnt lgkmcnt(5)
    buffer_store_dwordx4 v[56:59], v80, s[24:27], s48 offen offset:3072 sc1
    s_waitcnt lgkmcnt(4)
    buffer_store_dwordx4 v[60:63], v83, s[24:27], s48 offen sc1
    s_waitcnt lgkmcnt(3)
    buffer_store_dwordx4 v[64:67], v80, s[24:27], s49 offen offset:0 sc1
    s_waitcnt lgkmcnt(2)
    buffer_store_dwordx4 v[68:71], v81, s[24:27], s49 offen offset:1024 sc1
    s_waitcnt lgkmcnt(1)
    buffer_store_dwordx4 v[72:75], v82, s[24:27], s49 offen offset:2048 sc1
    s_waitcnt lgkmcnt(0)
    buffer_store_dwordx4 v[76:79], v80, s[24:27], s49 offen offset:3072 sc1
    s_add_u32 s48, s48, 294912
    s_add_u32 s49, s49, 294912
    s_cmp_eq_u32 s37, 112992
    s_cbranch_scc0 L_nps2
    v_mov_b32 v97, 328704
    s_waitcnt vmcnt(18)
    ds_write_b32 v96, v97
L_nps2:
    s_cmp_lt_u32 s37, 195168
    s_cbranch_scc1 L_poll
    s_endpgm
L_wait:
    s_mov_b64 exec, 15
L_wait1:
    ds_read_b32 v95, v94
    s_waitcnt lgkmcnt(0)
    v_cmp_gt_u32 vcc, s52, v95
    s_cbranch_vccnz L_wait1
    s_mov_b64 exec, -1
    s_branch L_go
L_compute:
    s_lshl_b32 s3, s28, 2
    s_add_u32 s3, s3, 154080
    v_mov_b32 v96, s3
    s_mul_i32 s3, s28, 1536
    s_sub_u32 s3, s3, 1536
    v_and_b32 v5, 15, v0
    v_lshrrev_b32 v6, 4, v0
    v_bfe_u32 v7, v0, 2, 1
    v_bfe_u32 v8, v0, 3, 1
    v_bfe_u32 v9, v0, 1, 1
    v_and_b32 v10, 3, v0
    v_lshlrev_b32 v94, 2, v10
    v_add_u32 v94, 154080, v94
    v_mov_b32 v111, 154080
    v_lshl_add_u32 v11, v8, 2, v10
    v_mul_u32_u24 v11, 192, v11
    v_mul_u32_u24 v12, 10272, v7
    v_add3_u32 v11, v11, v12, s3
    v_mul_u32_u24 v12, 5136, v6
    v_add_u32 v12, 20608, v12
    v_add_u32 v92, v11, v12
    v_subrev_u32 v90, 30816, v92
    v_subrev_u32 v11, 71904, v11
    v_xor_b32 v12, v6, v9
    v_lshl_add_u32 v98, v12, 4, v11
    v_add_u32 v93, 154096, v4
    v_lshl_add_u32 v11, v8, 3, v7
    v_lshl_add_u32 v11, v6, 1, v11
    v_mul_u32_u24 v11, 192, v11
    v_lshl_add_u32 v110, v10, 4, v11
    v_mul_u32_u24 v91, 0xaaaa, v7
    v_add_u32 v91, 0x4444, v91
    v_and_b32 v10, 1, v0
    v_lshrrev_b32 v12, 2, v5
    v_lshlrev_b32 v10, 4, v10
    v_mov_b32 v14, 0xffff
    v_lshlrev_b32 v14, v10, v14
    v_sub_u32 v13, v6, v9
    v_cmp_gt_u32 vcc, 3, v13
    v_mul_i32_i24 v13, 576, v13
    v_lshl_add_u32 v13, v12, 2, v13
    v_cndmask_b32 v15, 0, v14, vcc
    v_add_u32 v108, 18816, v13
    v_cmp_eq_u32 vcc, 0, v12
    v_bfe_u32 v10, v0, 4, 1
    v_lshlrev_b32 v10, 1, v10
    v_cndmask_b32 v100, 0, v15, vcc
    v_cmp_eq_u32 vcc, 1, v12
    v_sub_u32 v10, v10, v9
    v_mul_i32_i24 v11, 576, v10
    v_cndmask_b32 v101, 0, v15, vcc
    v_cmp_eq_u32 vcc, 2, v12
    v_lshrrev_b32 v13, 5, v0
    v_lshl_add_u32 v11, v12, 2, v11
    v_cndmask_b32 v102, 0, v15, vcc
    v_cmp_eq_u32 vcc, 3, v12
    v_mul_u32_u24 v13, 192, v13
    v_add_u32 v11, v11, v13
    v_cndmask_b32 v103, 0, v15, vcc
    v_cmp_le_i32 vcc, 0, v10
    v_add_u32 v109, 18432, v11
    s_nop 0
    v_cndmask_b32 v11, 0, v14, vcc
    v_cmp_gt_i32 vcc, 2, v10
    s_nop 1
    v_cndmask_b32 v13, 0, v14, vcc
    v_cmp_eq_u32 vcc, 0, v8
    s_nop 1
    v_cndmask_b32 v104, 0, v11, vcc
    v_cndmask_b32 v106, 0, v13, vcc
    v_xor_b32 v105, v104, v11
    v_xor_b32 v107, v106, v13
L_w_dw:
    ds_read_b32 v95, v111
    s_waitcnt lgkmcnt(0)
    v_cmp_gt_u32 vcc, 5136, v95
    s_cbranch_vccnz L_w_dw
    ds_read2_b32 v[16:17], v109 offset0:0 offset1:144
    ds_read2_b32 v[18:19], v109 offset0:4 offset1:148
    ds_read2_b32 v[20:21], v109 offset0:8 offset1:152
    ds_read2_b32 v[22:23], v109 offset0:12 offset1:156
    ds_read2_b32 v[24:25], v109 offset0:16 offset1:160
    ds_read2_b32 v[26:27], v109 offset0:20 offset1:164
    ds_read2_b32 v[28:29], v109 offset0:24 offset1:168
    ds_read2_b32 v[30:31], v109 offset0:28 offset1:172
    ds_read2_b32 v[32:33], v109 offset0:32 offset1:176
    ds_read2_b32 v[34:35], v109 offset0:36 offset1:180
    ds_read2_b32 v[36:37], v109 offset0:40 offset1:184
    ds_read2_b32 v[38:39], v109 offset0:44 offset1:188
    s_waitcnt lgkmcnt(6)
    ds_read2_b32 v[40:41], v108 offset0:0 offset1:4
    ds_read2_b32 v[42:43], v108 offset0:8 offset1:12
    ds_read2_b32 v[44:45], v108 offset0:16 offset1:20
    ds_read2_b32 v[46:47], v108 offset0:24 offset1:28
    ds_read2_b32 v[48:49], v108 offset0:32 offset1:36
    ds_read2_b32 v[50:51], v108 offset0:40 offset1:44
    v_and_b32 v160, v104, v16
    v_and_b32 v161, v105, v16
    v_and_b32 v162, v106, v17
    v_and_b32 v163, v107, v17
    v_and_b32 v168, v104, v18
    v_and_b32 v169, v105, v18
    v_and_b32 v170, v106, v19
    v_and_b32 v171, v107, v19
    v_and_b32 v176, v104, v20
    v_and_b32 v177, v105, v20
    v_and_b32 v178, v106, v21
    v_and_b32 v179, v107, v21
    v_and_b32 v184, v104, v22
    v_and_b32 v185, v105, v22
    v_and_b32 v186, v106, v23
    v_and_b32 v187, v107, v23
    v_and_b32 v192, v104, v24
    v_and_b32 v193, v105, v24
    v_and_b32 v194, v106, v25
    v_and_b32 v195, v107, v25
    v_and_b32 v200, v104, v26
    v_and_b32 v201, v105, v26
    v_and_b32 v202, v106, v27
    v_and_b32 v203, v107, v27
    s_waitcnt lgkmcnt(0)
    v_and_b32 v208, v104, v28
    v_and_b32 v209, v105, v28
    v_and_b32 v210, v106, v29
    v_and_b32 v211, v107, v29
    v_and_b32 v216, v104, v30
    v_and_b32 v217, v105, v30
    v_and_b32 v218, v106, v31
    v_and_b32 v219, v107, v31
    v_and_b32 v224, v104, v32
    v_and_b32 v225, v105, v32
    v_and_b32 v226, v106, v33
    v_and_b32 v227, v107, v33
    v_and_b32 v232, v104, v34
    v_and_b32 v233, v105, v34
    v_and_b32 v234, v106, v35
    v_and_b32 v235, v107, v35
    v_and_b32 v240, v104, v36
    v_and_b32 v241, v105, v36
    v_and_b32 v242, v106, v37
    v_and_b32 v243, v107, v37
    v_and_b32 v248, v104, v38
    v_and_b32 v249, v105, v38
    v_and_b32 v250, v106, v39
    v_and_b32 v251, v107, v39
    v_and_b32 v164, v100, v40
    v_and_b32 v165, v101, v40
    v_and_b32 v166, v102, v40
    v_and_b32 v167, v103, v40
    v_and_b32 v172, v100, v41
    v_and_b32 v173, v101, v41
    v_and_b32 v174, v102, v41
    v_and_b32 v175, v103, v41
    v_and_b32 v180, v100, v42
    v_and_b32 v181, v101, v42
    v_and_b32 v182, v102, v42
    v_and_b32 v183, v103, v42
    v_and_b32 v188, v100, v43
    v_and_b32 v189, v101, v43
    v_and_b32 v190, v102, v43
    v_and_b32 v191, v103, v43
    v_and_b32 v196, v100, v44
    v_and_b32 v197, v101, v44
    v_and_b32 v198, v102, v44
    v_and_b32 v199, v103, v44
    v_and_b32 v204, v100, v45
    v_and_b32 v205, v101, v45
    v_and_b32 v206, v102, v45
    v_and_b32 v207, v103, v45
    v_and_b32 v212, v100, v46
    v_and_b32 v213, v101, v46
    v_and_b32 v214, v102, v46
    v_and_b32 v215, v103, v46
    v_and_b32 v220, v100, v47
    v_and_b32 v221, v101, v47
    v_and_b32 v222, v102, v47
    v_and_b32 v223, v103, v47
    v_and_b32 v228, v100, v48
    v_and_b32 v229, v101, v48
    v_and_b32 v230, v102, v48
    v_and_b32 v231, v103, v48
    v_and_b32 v236, v100, v49
    v_and_b32 v237, v101, v49
    v_and_b32 v238, v102, v49
    v_and_b32 v239, v103, v49
    v_and_b32 v244, v100, v50
    v_and_b32 v245, v101, v50
    v_and_b32 v246, v102, v50
    v_and_b32 v247, v103, v50
    v_and_b32 v252, v100, v51
    v_and_b32 v253, v101, v51
    v_and_b32 v254, v102, v51
    v_and_b32 v255, v103, v51
    v_and_b32 v5, 31, v0
    v_lshrrev_b32 v6, 5, v0
    v_lshlrev_b32 v8, 4, v5
    v_add_u32 v8, 1024, v8
    s_add_u32 s32, s3, 102720
    s_add_u32 s33, s3, s31
    v_add_u32 v86, s32, v4
    v_mul_u32_u24 v9, 10272, v6
    v_add3_u32 v87, v8, v9, s32
    v_add_u32 v88, s33, v4
    v_mul_u32_u24 v9, 147456, v6
    v_add3_u32 v89, v8, v9, s33
    s_mov_b64 s[24:25], s[10:11]
    s_mov_b32 s26, 28311552
    s_mov_b32 s27, 0x20000
    s_add_u32 s46, s46, 1474560
    s_add_u32 s47, s46, 73728
    s_add_u32 s48, s47, 73728
    s_add_u32 s49, s48, 73728
    v_add_u32 v7, 0, v0
    v_mul_u32_u24 v7, 2731, v7
    v_bfe_u32 v7, v7, 16, 1
    v_lshlrev_b32 v7, 4, v7
    v_xor_b32 v88, v88, v7
    v_add_u32 v7, 16, v5
    v_mul_u32_u24 v7, 2731, v7
    v_bfe_u32 v7, v7, 16, 1
    v_lshlrev_b32 v7, 4, v7
    v_xor_b32 v89, v89, v7
    s_waitcnt vmcnt(0)
L_w_pw:
    ds_read_b32 v95, v111
    s_waitcnt lgkmcnt(0)
    v_cmp_gt_u32 vcc, 30816, v95
    s_cbranch_vccnz L_w_pw
    ds_read_b64_tr_b16 a[0:1], v110 offset:0
    ds_read_b64_tr_b16 a[2:3], v110 offset:3072
    ds_read_b64_tr_b16 a[4:5], v110 offset:8
    ds_read_b64_tr_b16 a[6:7], v110 offset:3080
    ds_read_b64_tr_b16 a[8:9], v110 offset:64
    ds_read_b64_tr_b16 a[10:11], v110 offset:3136
    ds_read_b64_tr_b16 a[12:13], v110 offset:72
    ds_read_b64_tr_b16 a[14:15], v110 offset:3144
    ds_read_b64_tr_b16 a[16:17], v110 offset:128
    ds_read_b64_tr_b16 a[18:19], v110 offset:3200
    ds_read_b64_tr_b16 a[20:21], v110 offset:136
    ds_read_b64_tr_b16 a[22:23], v110 offset:3208
    s_waitcnt lgkmcnt(3)
    ds_read_b64_tr_b16 a[24:25], v110 offset:6144
    ds_read_b64_tr_b16 a[26:27], v110 offset:9216
    ds_read_b64_tr_b16 a[28:29], v110 offset:6152
    ds_read_b64_tr_b16 a[30:31], v110 offset:9224
    ds_read_b64_tr_b16 a[32:33], v110 offset:6208
    ds_read_b64_tr_b16 a[34:35], v110 offset:9280
    ds_read_b64_tr_b16 a[36:37], v110 offset:6216
    ds_read_b64_tr_b16 a[38:39], v110 offset:9288
    ds_read_b64_tr_b16 a[40:41], v110 offset:6272
    ds_read_b64_tr_b16 a[42:43], v110 offset:9344
    ds_read_b64_tr_b16 a[44:45], v110 offset:6280
    ds_read_b64_tr_b16 a[46:47], v110 offset:9352
    s_waitcnt lgkmcnt(3)
    ds_read_b64_tr_b16 a[48:49], v110 offset:12288
    ds_read_b64_tr_b16 a[50:51], v110 offset:15360
    ds_read_b64_tr_b16 a[52:53], v110 offset:12296
    ds_read_b64_tr_b16 a[54:55], v110 offset:15368
    ds_read_b64_tr_b16 a[56:57], v110 offset:12352
    ds_read_b64_tr_b16 a[58:59], v110 offset:15424
    ds_read_b64_tr_b16 a[60:61], v110 offset:12360
    ds_read_b64_tr_b16 a[62:63], v110 offset:15432
    ds_read_b64_tr_b16 a[64:65], v110 offset:12416
    ds_read_b64_tr_b16 a[66:67], v110 offset:15488
    ds_read_b64_tr_b16 a[68:69], v110 offset:12424
    ds_read_b64_tr_b16 a[70:71], v110 offset:15496
    v_mov_b32 v97, 51360
    s_mov_b32 s52, 51360
    s_waitcnt lgkmcnt(3)
    ds_write_b32 v96, v97
    s_waitcnt lgkmcnt(0)
    ds_read_b128 a[80:83], v92 offset:384
    ds_read_b128 a[72:75], v92 offset:0
    ds_read_b128 a[76:79], v92 offset:192
    ds_read_b128 a[92:95], v92 offset:400
    ds_read_b128 a[84:87], v92 offset:16
    ds_read_b128 a[88:91], v92 offset:208
    ds_read_b128 a[104:107], v92 offset:416
    ds_read_b128 a[96:99], v92 offset:32
    ds_read_b128 a[100:103], v92 offset:224
    ds_read_b128 a[116:119], v92 offset:432
    ds_read_b128 a[108:111], v92 offset:48
    ds_read_b128 a[112:115], v92 offset:240
    s_waitcnt lgkmcnt(9)
    v_mfma_f32_16x16x32_bf16 v[72:75], v[164:167], a[80:83], 0
    v_smfmac_f32_16x16x64_bf16 v[72:75], v[160:163], a[72:79], v91
    ds_read_b128 a[80:83], v92 offset:448
    ds_read_b128 a[72:75], v92 offset:64
    ds_read_b128 a[76:79], v92 offset:256
    s_waitcnt lgkmcnt(9)
    v_mfma_f32_16x16x32_bf16 v[76:79], v[172:175], a[92:95], 0
    s_nop 2
    v_cvt_pk_bf16_f32 v0, v72, v73
    v_cvt_pk_bf16_f32 v12, v74, v75
    v_smfmac_f32_16x16x64_bf16 v[76:79], v[168:171], a[84:91], v91
    ds_read_b128 a[92:95], v92 offset:464
    ds_read_b128 a[84:87], v92 offset:80
    ds_read_b128 a[88:91], v92 offset:272
    s_waitcnt lgkmcnt(6)
    v_mfma_f32_16x16x32_bf16 v[72:75], v[180:183], a[104:107], 0
    s_nop 2
    v_cvt_pk_bf16_f32 v1, v76, v77
    v_cvt_pk_bf16_f32 v13, v78, v79
    v_smfmac_f32_16x16x64_bf16 v[72:75], v[176:179], a[96:103], v91
    ds_read_b128 a[104:107], v92 offset:480
    ds_read_b128 a[96:99], v92 offset:96
    ds_read_b128 a[100:103], v92 offset:288
    v_mfma_f32_16x16x32_bf16 v[76:79], v[188:191], a[116:119], 0
    s_nop 3
    v_cvt_pk_bf16_f32 v2, v72, v73
    v_cvt_pk_bf16_f32 v14, v74, v75
    v_smfmac_f32_16x16x64_bf16 v[76:79], v[184:187], a[108:115], v91
    ds_read_b128 a[116:119], v92 offset:496
    ds_read_b128 a[108:111], v92 offset:112
    ds_read_b128 a[112:115], v92 offset:304
    s_waitcnt lgkmcnt(6)
    v_mfma_f32_16x16x32_bf16 v[72:75], v[196:199], a[80:83], 0
    s_nop 2
    v_cvt_pk_bf16_f32 v3, v76, v77
    v_cvt_pk_bf16_f32 v15, v78, v79
    v_smfmac_f32_16x16x64_bf16 v[72:75], v[192:195], a[72:79], v91
    ds_read_b128 a[80:83], v92 offset:512
    ds_read_b128 a[72:75], v92 offset:128
    s_branch L_join
L_unit:
    s_waitcnt lgkmcnt(9)
    v_mfma_f32_16x16x32_bf16 v[72:75], v[164:167], a[80:83], 0
    v_cvt_pk_bf16_f32 v11, v76, v77
    v_cvt_pk_bf16_f32 v23, v78, v79
    v_smfmac_f32_16x16x64_bf16 v[72:75], v[160:163], a[72:79], v91
    ds_read_b128 a[80:83], v92 offset:448
    v_mfma_f32_16x16x32_bf16 v[24:27], a[48:51], v[8:11], v[24:27]
    ds_read_b128 a[72:75], v92 offset:64
    v_mfma_f32_16x16x32_bf16 v[48:51], a[48:51], v[20:23], v[48:51]
    ds_read_b128 a[76:79], v92 offset:256
    v_mfma_f32_16x16x32_bf16 v[52:55], a[52:55], v[20:23], v[52:55]
    s_waitcnt lgkmcnt(9)
    v_mfma_f32_16x16x32_bf16 v[76:79], v[172:175], a[92:95], 0
    v_cvt_pk_bf16_f32 v0, v72, v73
    v_cvt_pk_bf16_f32 v12, v74, v75
    v_smfmac_f32_16x16x64_bf16 v[76:79], v[168:171], a[84:91], v91
    ds_read_b128 a[92:95], v92 offset:464
    v_cvt_pk_bf16_f32 v112, v24, v25
    v_cvt_pk_bf16_f32 v113, v26, v27
    v_mfma_f32_16x16x32_bf16 v[28:31], a[52:55], v[8:11], v[28:31]
    ds_read_b128 a[84:87], v92 offset:80
    v_cvt_pk_bf16_f32 v124, v48, v49
    v_cvt_pk_bf16_f32 v125, v50, v51
    v_mfma_f32_16x16x32_bf16 v[32:35], a[56:59], v[8:11], v[32:35]
    ds_read_b128 a[88:91], v92 offset:272
    v_cvt_pk_bf16_f32 v126, v52, v53
    v_cvt_pk_bf16_f32 v127, v54, v55
    v_mfma_f32_16x16x32_bf16 v[56:59], a[56:59], v[20:23], v[56:59]
    s_waitcnt lgkmcnt(6)
    v_mfma_f32_16x16x32_bf16 v[72:75], v[180:183], a[104:107], 0
    v_cvt_pk_bf16_f32 v1, v76, v77
    v_cvt_pk_bf16_f32 v13, v78, v79
    v_smfmac_f32_16x16x64_bf16 v[72:75], v[176:179], a[96:103], v91
    ds_read_b128 a[104:107], v92 offset:480
    ds_read_b128 a[96:99], v92 offset:96
    v_cvt_pk_bf16_f32 v114, v28, v29
    v_mfma_f32_16x16x32_bf16 v[60:63], a[60:63], v[20:23], v[60:63]
    ds_read_b128 a[100:103], v92 offset:288
    v_cvt_pk_bf16_f32 v115, v30, v31
    v_cvt_pk_bf16_f32 v116, v32, v33
    v_mfma_f32_16x16x32_bf16 v[36:39], a[60:63], v[8:11], v[36:39]
    ds_write_b128 v93, v[124:127] offset:5136
    v_mfma_f32_16x16x32_bf16 v[40:43], a[64:67], v[8:11], v[40:43]
    v_cvt_pk_bf16_f32 v117, v34, v35
    v_cvt_pk_bf16_f32 v128, v56, v57
    v_cvt_pk_bf16_f32 v129, v58, v59
    v_mfma_f32_16x16x32_bf16 v[76:79], v[188:191], a[116:119], 0
    v_cvt_pk_bf16_f32 v2, v72, v73
    v_cvt_pk_bf16_f32 v14, v74, v75
    v_smfmac_f32_16x16x64_bf16 v[76:79], v[184:187], a[108:115], v91
    ds_read_b128 a[116:119], v92 offset:496
    ds_read_b128 a[108:111], v92 offset:112
    v_cvt_pk_bf16_f32 v130, v60, v61
    v_mfma_f32_16x16x32_bf16 v[64:67], a[64:67], v[20:23], v[64:67]
    ds_read_b128 a[112:115], v92 offset:304
    v_cvt_pk_bf16_f32 v131, v62, v63
    v_cvt_pk_bf16_f32 v118, v36, v37
    v_mfma_f32_16x16x32_bf16 v[68:71], a[68:71], v[20:23], v[68:71]
    ds_write_b128 v93, v[112:115] offset:0
    v_mfma_f32_16x16x32_bf16 v[44:47], a[68:71], v[8:11], v[44:47]
    v_cvt_pk_bf16_f32 v119, v38, v39
    v_cvt_pk_bf16_f32 v120, v40, v41
    s_waitcnt lgkmcnt(6)
    v_mfma_f32_16x16x32_bf16 v[72:75], v[196:199], a[80:83], 0
    v_cvt_pk_bf16_f32 v3, v76, v77
    v_cvt_pk_bf16_f32 v15, v78, v79
    v_smfmac_f32_16x16x64_bf16 v[72:75], v[192:195], a[72:79], v91
    ds_read_b128 a[80:83], v92 offset:512
    ds_read_b128 a[72:75], v92 offset:128
    v_cvt_pk_bf16_f32 v121, v42, v43
L_join:
    v_mfma_f32_16x16x32_bf16 v[24:27], a[0:3], v[0:3], 0
    ds_read_b128 a[76:79], v92 offset:320
    v_cvt_pk_bf16_f32 v132, v64, v65
    v_cvt_pk_bf16_f32 v133, v66, v67
    v_mfma_f32_16x16x32_bf16 v[48:51], a[0:3], v[12:15], 0
    ds_write_b128 v93, v[128:131] offset:5200
    v_mfma_f32_16x16x32_bf16 v[52:55], a[4:7], v[12:15], 0
    v_cvt_pk_bf16_f32 v134, v68, v69
    v_cvt_pk_bf16_f32 v135, v70, v71
    v_cvt_pk_bf16_f32 v122, v44, v45
    v_mfma_f32_16x16x32_bf16 v[76:79], v[204:207], a[92:95], 0
    v_cvt_pk_bf16_f32 v4, v72, v73
    v_cvt_pk_bf16_f32 v16, v74, v75
    v_smfmac_f32_16x16x64_bf16 v[76:79], v[200:203], a[84:91], v91
    ds_read_b128 a[92:95], v92 offset:528
    ds_read_b128 a[84:87], v92 offset:144
    v_cvt_pk_bf16_f32 v123, v46, v47
    v_mfma_f32_16x16x32_bf16 v[28:31], a[4:7], v[0:3], 0
    ds_read_b128 a[88:91], v92 offset:336
    v_mfma_f32_16x16x32_bf16 v[32:35], a[8:11], v[0:3], 0
    ds_write_b128 v93, v[116:119] offset:64
    v_mfma_f32_16x16x32_bf16 v[56:59], a[8:11], v[12:15], 0
    s_waitcnt lgkmcnt(6)
    v_mfma_f32_16x16x32_bf16 v[72:75], v[212:215], a[104:107], 0
    v_cvt_pk_bf16_f32 v5, v76, v77
    v_cvt_pk_bf16_f32 v17, v78, v79
    v_smfmac_f32_16x16x64_bf16 v[72:75], v[208:211], a[96:103], v91
    ds_read_b128 a[104:107], v92 offset:544
    ds_read_b128 a[96:99], v92 offset:160
    v_mfma_f32_16x16x32_bf16 v[60:63], a[12:15], v[12:15], 0
    ds_read_b128 a[100:103], v92 offset:352
    v_mfma_f32_16x16x32_bf16 v[36:39], a[12:15], v[0:3], 0
    ds_write_b128 v93, v[132:135] offset:5264
    v_mfma_f32_16x16x32_bf16 v[40:43], a[16:19], v[0:3], 0
    v_mfma_f32_16x16x32_bf16 v[76:79], v[220:223], a[116:119], 0
    v_cvt_pk_bf16_f32 v6, v72, v73
    v_cvt_pk_bf16_f32 v18, v74, v75
    v_smfmac_f32_16x16x64_bf16 v[76:79], v[216:219], a[108:115], v91
    ds_read_b128 a[116:119], v92 offset:560
    ds_read_b128 a[108:111], v92 offset:176
    v_mfma_f32_16x16x32_bf16 v[64:67], a[16:19], v[12:15], 0
    ds_read_b128 a[112:115], v92 offset:368
    v_add_u32 v97, 20544, v97
    v_mfma_f32_16x16x32_bf16 v[68:71], a[20:23], v[12:15], 0
    ds_write_b128 v93, v[120:123] offset:128
    v_mfma_f32_16x16x32_bf16 v[44:47], a[20:23], v[0:3], 0
    s_waitcnt lgkmcnt(6)
    v_mfma_f32_16x16x32_bf16 v[72:75], v[228:231], a[80:83], 0
    v_cvt_pk_bf16_f32 v7, v76, v77
    v_cvt_pk_bf16_f32 v19, v78, v79
    v_smfmac_f32_16x16x64_bf16 v[72:75], v[224:227], a[72:79], v91
    ds_write_b32 v96, v97
    v_mfma_f32_16x16x32_bf16 v[24:27], a[24:27], v[4:7], v[24:27]
    s_min_u32 s53, s52, 133536
    v_mfma_f32_16x16x32_bf16 v[48:51], a[24:27], v[16:19], v[48:51]
    v_mfma_f32_16x16x32_bf16 v[52:55], a[28:31], v[16:19], v[52:55]
    ds_read_b32 v95, v94
    v_mfma_f32_16x16x32_bf16 v[76:79], v[236:239], a[92:95], 0
    s_nop 0
    v_cvt_pk_bf16_f32 v8, v72, v73
    v_cvt_pk_bf16_f32 v20, v74, v75
    v_smfmac_f32_16x16x64_bf16 v[76:79], v[232:235], a[84:91], v91
    v_mfma_f32_16x16x32_bf16 v[28:31], a[28:31], v[4:7], v[28:31]
    v_add_u32 v92, s53, v90
    v_mfma_f32_16x16x32_bf16 v[32:35], a[32:35], v[4:7], v[32:35]
    v_mfma_f32_16x16x32_bf16 v[56:59], a[32:35], v[16:19], v[56:59]
    s_waitcnt lgkmcnt(0)
    v_cmp_gt_u32 vcc, s52, v95
    s_cbranch_vccnz L_wait
L_go:
    v_mfma_f32_16x16x32_bf16 v[72:75], v[244:247], a[104:107], 0
    v_cvt_pk_bf16_f32 v9, v76, v77
    v_cvt_pk_bf16_f32 v21, v78, v79
    v_smfmac_f32_16x16x64_bf16 v[72:75], v[240:243], a[96:103], v91
    ds_read_b128 a[80:83], v92 offset:384
    ds_read_b128 a[72:75], v92 offset:0
    v_mfma_f32_16x16x32_bf16 v[60:63], a[36:39], v[16:19], v[60:63]
    ds_read_b128 a[76:79], v92 offset:192
    ds_read_b128 a[92:95], v92 offset:400
    v_mfma_f32_16x16x32_bf16 v[36:39], a[36:39], v[4:7], v[36:39]
    ds_read_b128 a[84:87], v92 offset:16
    ds_read_b128 a[88:91], v92 offset:208
    v_mfma_f32_16x16x32_bf16 v[40:43], a[40:43], v[4:7], v[40:43]
    ds_read_b128 a[104:107], v92 offset:416
    ds_read_b128 a[96:99], v92 offset:32
    v_mfma_f32_16x16x32_bf16 v[76:79], v[252:255], a[116:119], 0
    v_cvt_pk_bf16_f32 v10, v72, v73
    v_cvt_pk_bf16_f32 v22, v74, v75
    v_smfmac_f32_16x16x64_bf16 v[76:79], v[248:251], a[108:115], v91
    ds_read_b128 a[100:103], v92 offset:224
    ds_read_b128 a[116:119], v92 offset:432
    v_mfma_f32_16x16x32_bf16 v[64:67], a[40:43], v[16:19], v[64:67]
    ds_read_b128 a[108:111], v92 offset:48
    ds_read_b128 a[112:115], v92 offset:240
    v_mfma_f32_16x16x32_bf16 v[68:71], a[44:47], v[16:19], v[68:71]
    s_add_u32 s52, s52, 20544
    s_cmp_lt_u32 s52, 174624
    v_mfma_f32_16x16x32_bf16 v[44:47], a[44:47], v[4:7], v[44:47]
    v_add_u32 v93, s52, v98
    s_cbranch_scc1 L_unit
    v_cvt_pk_bf16_f32 v11, v76, v77
    v_cvt_pk_bf16_f32 v23, v78, v79
    s_nop 0
    v_mfma_f32_16x16x32_bf16 v[24:27], a[48:51], v[8:11], v[24:27]
    v_mfma_f32_16x16x32_bf16 v[28:31], a[52:55], v[8:11], v[28:31]
    v_mfma_f32_16x16x32_bf16 v[32:35], a[56:59], v[8:11], v[32:35]
    v_mfma_f32_16x16x32_bf16 v[36:39], a[60:63], v[8:11], v[36:39]
    v_mfma_f32_16x16x32_bf16 v[40:43], a[64:67], v[8:11], v[40:43]
    v_mfma_f32_16x16x32_bf16 v[44:47], a[68:71], v[8:11], v[44:47]
    s_waitcnt lgkmcnt(0)
    v_mfma_f32_16x16x32_bf16 v[48:51], a[48:51], v[20:23], v[48:51]
    v_mfma_f32_16x16x32_bf16 v[52:55], a[52:55], v[20:23], v[52:55]
    v_mfma_f32_16x16x32_bf16 v[56:59], a[56:59], v[20:23], v[56:59]
    v_cvt_pk_bf16_f32 v112, v24, v25
    v_cvt_pk_bf16_f32 v113, v26, v27
    v_mfma_f32_16x16x32_bf16 v[60:63], a[60:63], v[20:23], v[60:63]
    v_cvt_pk_bf16_f32 v114, v28, v29
    v_cvt_pk_bf16_f32 v115, v30, v31
    v_mfma_f32_16x16x32_bf16 v[64:67], a[64:67], v[20:23], v[64:67]
    v_cvt_pk_bf16_f32 v116, v32, v33
    ds_write_b128 v93, v[112:115] offset:0
    v_mfma_f32_16x16x32_bf16 v[68:71], a[68:71], v[20:23], v[68:71]
    v_cvt_pk_bf16_f32 v117, v34, v35
    v_cvt_pk_bf16_f32 v118, v36, v37
    v_cvt_pk_bf16_f32 v119, v38, v39
    v_cvt_pk_bf16_f32 v120, v40, v41
    v_cvt_pk_bf16_f32 v121, v42, v43
    ds_write_b128 v93, v[116:119] offset:64
    v_cvt_pk_bf16_f32 v122, v44, v45
    v_cvt_pk_bf16_f32 v123, v46, v47
    v_cvt_pk_bf16_f32 v124, v48, v49
    v_cvt_pk_bf16_f32 v125, v50, v51
    ds_write_b128 v93, v[120:123] offset:128
    v_cvt_pk_bf16_f32 v126, v52, v53
    v_cvt_pk_bf16_f32 v127, v54, v55
    ds_read_b128 v[136:139], v86 offset:0
    ds_read_b128 v[140:143], v86 offset:10272
    ds_read_b128 v[144:147], v87 offset:0
    v_cvt_pk_bf16_f32 v128, v56, v57
    v_cvt_pk_bf16_f32 v129, v58, v59
    ds_write_b128 v93, v[124:127] offset:5136
    v_cvt_pk_bf16_f32 v130, v60, v61
    v_cvt_pk_bf16_f32 v131, v62, v63
    v_cvt_pk_bf16_f32 v132, v64, v65
    v_cvt_pk_bf16_f32 v133, v66, v67
    ds_write_b128 v93, v[128:131] offset:5200
    v_cvt_pk_bf16_f32 v134, v68, v69
    v_cvt_pk_bf16_f32 v135, v70, v71
    s_nop 1
    ds_write_b128 v93, v[132:135] offset:5264
    ds_read_b128 v[148:151], v86 offset:5136
    ds_read_b128 v[152:155], v86 offset:15408
    ds_read_b128 v[156:159], v87 offset:5136
    s_waitcnt lgkmcnt(6)
    buffer_store_dwordx4 v[136:139], v88, s[24:27], s46 offen sc1
    buffer_store_dwordx4 v[140:143], v88, s[24:27], s48 offen sc1
    buffer_store_dwordx4 v[144:147], v89, s[24:27], s46 offen sc1
    s_waitcnt lgkmcnt(2)
    buffer_store_dwordx4 v[148:151], v88, s[24:27], s47 offen sc1
    s_waitcnt lgkmcnt(1)
    buffer_store_dwordx4 v[152:155], v88, s[24:27], s49 offen sc1
    s_waitcnt lgkmcnt(0)
    buffer_store_dwordx4 v[156:159], v89, s[24:27], s47 offen sc1
L_end:
    s_endpgm
.section .rodata,"a"
.p2align 6
.amdhsa_kernel standalone__depthwise_separable__vision_kernel
  .amdhsa_next_free_vgpr 376
  .amdhsa_next_free_sgpr 64
  .amdhsa_accum_offset 256
  .amdhsa_group_segment_fixed_size 0
  .amdhsa_kernarg_size 48
  .amdhsa_user_sgpr_count 2
  .amdhsa_user_sgpr_kernarg_segment_ptr 1
  .amdhsa_system_sgpr_workgroup_id_x 1
.end_amdhsa_kernel
```
